```python
import torch

def _softmax(x, axis=-1):
    return torch.softmax(x, dim=axis)
def _gelu(x):
    return torch.nn.functional.gelu(x, approximate="tanh")
def _silu(x):
    return torch.nn.functional.silu(x)
def _sigmoid(x):
    return torch.sigmoid(x)
def _layernorm(x, axis=-1, eps=1e-5):
    m = x.mean(dim=axis, keepdim=True)
    v = x.var(dim=axis, keepdim=True, unbiased=False)
    return (x - m) / torch.sqrt(v + eps)
def _scatter_add(tgt, idx, src, axis=0):
    return tgt.clone().index_add_(axis, idx, src)
def _segment_sum(src, seg, n):
    out = torch.zeros((n,) + src.shape[1:], dtype=src.dtype)
    return out.index_add_(0, seg, src)
def _pad(x, pw):
    flat = tuple(v for pair in reversed(pw) for v in pair)
    return torch.nn.functional.pad(x, flat)

kernel_name = 'gated_mix__sliding_block_cached__swiglu_ffn__decode'

def setup_inputs():

    _w = (lambda a: (lambda t: t.to(torch.bfloat16) if t.is_floating_point() else t)(torch.as_tensor(a)))
    def _A_setup():
        B, Sq, D = 1, 1, 448
        Hq, Hkv, Sk, Dh = 16, 8, 65536, 256
        assert Hq % Hkv == 0, (Hq, Hkv)
        return {
            "x": _w((lambda *s: torch.randn(*s, dtype=torch.bfloat16) * 0.05)(B, Sq, D)),
            "k_cache": _w((lambda *s: torch.randn(*s, dtype=torch.bfloat16) * 3.2)(B, Hkv, Sk, Dh)),
            "v_cache": _w((lambda *s: torch.randn(*s, dtype=torch.bfloat16) * 0.4)(B, Hkv, Sk, Dh)),
            "wq": _w((lambda *s: torch.randn(*s, dtype=torch.bfloat16) * 3.2)(D, Hq * Dh) * (D ** -0.5)),
            "wo": _w((lambda *s: torch.randn(*s, dtype=torch.bfloat16) * 0.4)(Hq * Dh, D) * ((Hq * Dh) ** -0.5)),
        }
    _A_in = _A_setup()

    def _B_setup():
        B, S, D, F = 1, 1, 448, 1792
        return {
            "x": _w((lambda *s: torch.randn(*s, dtype=torch.bfloat16) * 0.05)(B, S, D)),
            "w_gate": _w((lambda *s: torch.randn(*s, dtype=torch.bfloat16) * 0.05)(D, F)),
            "w_up": _w((lambda *s: torch.randn(*s, dtype=torch.bfloat16) * 0.05)(D, F)),
            "w_down": _w((lambda *s: torch.randn(*s, dtype=torch.bfloat16) * 0.05)(F, D)),
        }
    _B_in = _B_setup()

    return {
        "A_x": _A_in["x"],
        "A_k_cache": _A_in["k_cache"],
        "A_v_cache": _A_in["v_cache"],
        "A_wq": _A_in["wq"],
        "A_wo": _A_in["wo"],
        "B_x": _B_in["x"],
        "B_w_gate": _B_in["w_gate"],
        "B_w_up": _B_in["w_up"],
        "B_w_down": _B_in["w_down"],
        "gate_w": _w((lambda *s: torch.randn(*s, dtype=torch.bfloat16) * 0.05)(448) * 16.0),
    }

def reference(A_x, A_k_cache, A_v_cache, A_wq, A_wo, B_x, B_w_gate, B_w_up, B_w_down, gate_w):
    def _A_ref(x, k_cache, v_cache, wq, wo):
        B, Sq, D = x.shape
        Hq, Dh = 16, 256
        Hkv, Sk = k_cache.shape[1], k_cache.shape[2]
        W = min(4096, max(256, Sk // 4))
        rep = Hq // Hkv
        q = (lambda x, *d: x.permute(*d))((x @ wq).reshape(B, Sq, Hq, Dh), 0, 2, 1, 3)
        k = (lambda x, n, axis: torch.repeat_interleave(x, n, dim=axis))(k_cache[:, :, Sk - W:, :], rep, axis=1)
        v = (lambda x, n, axis: torch.repeat_interleave(x, n, dim=axis))(v_cache[:, :, Sk - W:, :], rep, axis=1)
        scores = torch.einsum("bhqd,bhkd->bhqk", q, k) * (Dh ** -0.5)
        p = _softmax(scores, axis=-1)
        o = torch.einsum("bhqk,bhkd->bhqd", p, v)
        return (lambda x, *d: x.permute(*d))(o, 0, 2, 1, 3).reshape(B, Sq, Hq * Dh) @ wo

    def _B_ref(x, w_gate, w_up, w_down):
        g = _silu(x @ w_gate)
        u = x @ w_up
        return (g * u) @ w_down

    x = A_x
    g = _sigmoid((x * gate_w).sum(-1, keepdims=True))
    a = _A_ref(x, A_k_cache, A_v_cache, A_wq, A_wo)
    b = _B_ref(x, B_w_gate, B_w_up, B_w_down)
    return g * a + (1 - g) * b
```

```asm
; @launch grid=(256,1,1) block=(576,1,1) lds=48288
.amdgcn_target "amdgcn-amd-amdhsa--gfx950"
.text
.globl gated_mix__sliding_block_cached__swiglu_ffn__decode_kernel
.p2align 8
.type gated_mix__sliding_block_cached__swiglu_ffn__decode_kernel,@function
gated_mix__sliding_block_cached__swiglu_ffn__decode_kernel:

    s_cmp_ge_u32 s2, 256
    s_cbranch_scc1 L_end
    s_load_dwordx16 s[4:19], s[0:1], 0
    s_load_dwordx8 s[20:27], s[0:1], 64
    s_load_dwordx2 s[28:29], s[0:1], 96
    v_lshrrev_b32 v2, 6, v0
    v_and_b32 v1, 63, v0
    s_and_b32 s31, s2, 7
    s_lshr_b32 s32, s2, 3
    v_readfirstlane_b32 s30, v2
    s_lshl_b32 s33, s31, 5
    s_add_u32 s33, s33, s32
    s_cmp_lg_u32 s30, 8
    s_cbranch_scc1 L_kv
    s_getpc_b64 s[34:35]
L_pc:
    s_lshl_b32 s36, s32, 8
    v_lshlrev_b32 v2, 2, v1
    v_add_u32 v2, s36, v2
    v_min_u32 v2, L_end-L_pc, v2
    global_load_dword v120, v2, s[34:35]
    s_waitcnt lgkmcnt(0)
    s_load_dword s57, s[28:29], 0
    s_barrier
    s_barrier
    s_barrier
    s_barrier
    s_branch L_helper
L_kv:
    s_lshr_b32 s34, s32, 3
    s_mul_i32 s34, s34, 7
    s_add_u32 s57, s34, s30
    s_lshl_b32 s34, s57, 7
    s_add_u32 s34, s34, s31
    s_and_b32 s35, s32, 7
    s_lshl3_add_u32 s34, s34, s35
    s_lshl_b32 s48, s34, 7
    s_lshl_b32 s39, 1, 17
    s_mov_b32 s47, s39
    s_lshl_b32 s50, 1, 16
    s_movk_i32 s38, 0x2000
    s_add_u32 s49, s30, s30
    s_add_u32 s49, s49, 1
    s_lshl_b32 s49, s49, 10
    s_lshl_b32 s34, s31, 9
    s_add_u32 s34, s34, s32
    s_lshl3_add_u32 s34, s34, s30
    s_lshl_b32 s34, s34, 13
    s_add_u32 s34, s34, 31457280
    s_mov_b32 s101, s30
    s_add_u32 s101, s101, s32
    s_add_u32 s101, s101, s31
    s_and_b32 s98, s101, 3
    s_lshl_b32 s98, s98, 11
    s_add_u32 s99, s101, 1
    s_and_b32 s99, s99, 3
    s_lshl_b32 s99, s99, 11
    v_lshrrev_b32 v8, 4, v1
    v_and_b32 v9, 3, v1
    v_lshl_add_u32 v2, v8, 2, v9
    v_lshlrev_b32 v2, 4, v2
    v_bfe_u32 v9, v1, 2, 2
    v_lshl_add_u32 v2, v9, 9, v2
    v_lshrrev_b32 v5, 3, v1
    v_and_b32 v4, 7, v1
    v_lshlrev_b32 v4, 4, v4
    s_cmp_eq_u32 s30, 7
    s_cselect_b32 s35, 7, 13
    v_lshl_add_u32 v6, v5, s35, v4
    s_cselect_b32 s48, 0, s48
    s_cselect_b32 m0, 0, s49
    s_cselect_b32 s46, 896, s50
    s_addk_i32 s49, 0x400
    s_cmp_eq_u32 s30, 7
    s_cmovk_i32 s49, 30720
    s_cbranch_scc1 L_w7
    s_mov_b32 s46, 123008
L_w7:
    s_waitcnt lgkmcnt(0)
    s_cselect_b64 s[44:45], s[4:5], s[10:11]
    s_add_u32 s44, s44, s48
    s_addc_u32 s45, s45, 0
    buffer_load_dwordx4 v6, s[44:47], 0 offen lds
    s_mov_b32 m0, s49
    s_add_u32 s36, s6, s34
    buffer_load_dwordx4 v6, s[44:47], s50 offen nt lds
    s_addc_u32 s37, s7, 0
    s_barrier
    buffer_load_dwordx4 v[16:19], v2, s[36:39], s98 offen offset:0 nt
    s_barrier
    buffer_load_dwordx4 v[20:23], v2, s[36:39], s98 offen offset:256 nt
    s_barrier
    buffer_load_dwordx4 v[24:27], v2, s[36:39], s99 offen offset:0 nt
    s_barrier
    buffer_load_dwordx4 v[28:31], v2, s[36:39], s99 offen offset:256 nt
    s_xor_b32 s100, s98, 0x1000
    s_xor_b32 s101, s99, 0x1000
    v_mul_u32_u24 v5, 3584, v5
    v_add_u32 v86, v5, v4
    v_and_b32 v9, 15, v1
    v_lshlrev_b32 v9, 4, v9
    v_lshl_add_u32 v3, v8, 9, v9
    s_add_u32 s40, s8, s34
    s_addc_u32 s41, s9, 0
    s_mov_b32 s42, s38
    s_mov_b32 s43, 0x20000
    v_and_b32 v10, 1, v1
    v_cmp_eq_u32 vcc, 1, v10
    v_mov_b32 v11, 0xffff
    v_mov_b32 v12, 0xffff0000
    v_bfe_u32 v10, v1, 1, 2
    v_cndmask_b32 v11, v11, v12, vcc
    v_cmp_eq_u32 vcc, 0, v10
    s_nop 1
    v_cndmask_b32 v4, 0, v11, vcc
    v_cmp_eq_u32 vcc, 1, v10
    s_nop 1
    v_cndmask_b32 v5, 0, v11, vcc
    v_cmp_eq_u32 vcc, 2, v10
    s_nop 1
    v_cndmask_b32 v6, 0, v11, vcc
    v_cmp_eq_u32 vcc, 3, v10
    s_nop 1
    v_cndmask_b32 v7, 0, v11, vcc
    s_mov_b32 s44, s28
    s_mov_b32 s45, s29
    s_mov_b32 s46, 1310720
    s_mov_b32 s47, 0x20000
    s_mul_i32 s34, s33, 14336
    s_add_u32 s48, s12, s34
    s_addc_u32 s49, s13, 0
    s_mov_b32 s50, 14336
    s_mov_b32 s51, 0x20000
    s_cmp_gt_u32 s31, 7
    s_subb_u32 s68, s31, 0
    s_lshl_b32 s34, s68, 5
    s_add_u32 s34, s34, s32
    s_mul_i32 s34, s34, 7168
    s_cmp_eq_u32 s31, 7
    s_cselect_b32 s34, 0, s34
    s_cselect_b32 s54, 0, 7168
    s_add_u32 s52, s20, s34
    s_addc_u32 s53, s21, 0
    s_mov_b32 s55, 0x20000
    s_movk_i32 s69, 7168
    v_mul_u32_u24 v104, 896, v8
    s_lshl_b32 s34, s30, 8
    v_add3_u32 v104, v104, v9, s34
    v_add_u32 v10, s34, v9
    v_cmp_le_u32 vcc, 896, v10
    v_mov_b32 v10, 0x7f000000
    s_nop 0
    v_cndmask_b32 v104, v104, v10, vcc
    v_bfe_u32 v10, v1, 3, 1
    v_lshlrev_b32 v106, 2, v10
    v_lshlrev_b32 v10, 9, v10
    v_and_b32 v11, 3, v1
    v_lshl_add_u32 v11, v8, 2, v11
    v_lshl_add_u32 v105, v11, 4, v10
    v_mov_b32 v107, 0
    s_mov_b32 s60, 0x01010101
    s_mov_b32 s61, 0x01010101
    s_mov_b32 s59, 0x3db8aa3b
    v_lshrrev_b32 v136, 3, v1
    v_lshlrev_b32 v136, 2, v136
    s_lshl_b32 s34, s30, 5
    v_add_u32 v136, s34, v136
    v_lshrrev_b32 v137, 5, v1
    v_lshlrev_b32 v137, 10, v137
    v_lshl_add_u32 v137, v9, 1, v137
    v_bfe_u32 v10, v1, 4, 1
    v_lshl_add_u32 v137, v10, 4, v137
    s_mul_i32 s34, s30, 2048
    v_add_u32 v137, s34, v137
    v_lshlrev_b32 v139, 2, v0
    v_add_u32 v138, 30720, v139
    v_lshlrev_b32 v140, 1, v9
    s_lshl_b32 s34, s30, 9
    v_add_u32 v140, s34, v140
    v_cmp_le_u32 vcc, 0x700, v140
    v_lshl_add_u32 v140, v10, 4, v140
    v_mov_b32 v12, 0x7f000000
    v_cndmask_b32 v140, v140, v12, vcc
    v_lshlrev_b32 v141, 4, v8
    s_lshl_b32 s3, s33, 11
    s_add_u32 s3, s3, 786432
    s_lshl_b32 s34, s33, 11
    s_add_u32 s34, s34, 262144
    s_mul_i32 s64, s57, 57344
    s_lshl_b32 s35, s68, 9
    s_add_u32 s64, s64, s35
    s_bfe_u32 s35, s32, 0x20001
    s_lshl_b32 s35, s35, 7
    s_add_u32 s64, s64, s35
    s_cmp_eq_u32 s31, 7
    s_cselect_b32 s64, 0, s64
    s_cselect_b32 s66, 0, 53888
    s_cmp_eq_u32 s30, 7
    s_cselect_b32 s64, 0, s64
    s_cselect_b32 s66, 0, s66
    s_cselect_b32 s35, 1024, 0
    s_lshl_b32 s58, s30, 11
    s_add_u32 s58, s58, s35
    s_bitcmp1_b32 s32, 0
    s_cselect_b32 s35, s18, s16
    s_cselect_b32 s65, s19, s17
    s_add_u32 s64, s64, s35
    s_addc_u32 s65, s65, 0
    s_mov_b32 s67, 0x20000
    s_movk_i32 s35, 28672
    s_waitcnt vmcnt(4)
    s_barrier
    s_waitcnt vmcnt(3)
    s_add_u32 m0, s58, 15360
    s_nop 0
    buffer_load_dwordx4 v86, s[64:67], 0 offen nt lds
    s_waitcnt vmcnt(3)
    s_add_u32 m0, s58, 16384
    s_nop 0
    buffer_load_dwordx4 v86, s[64:67], s35 offen nt lds
    s_waitcnt vmcnt(3)
    buffer_load_dwordx4 v[32:35], v2, s[36:39], s100 offen offset:0 nt
    s_waitcnt vmcnt(3)
    buffer_load_dwordx4 v[36:39], v2, s[36:39], s100 offen offset:256 nt
    s_waitcnt vmcnt(3)
    buffer_load_dwordx4 v[40:43], v2, s[36:39], s101 offen offset:0 nt
    s_waitcnt vmcnt(2)
    s_barrier
    buffer_load_dwordx4 v[44:47], v2, s[36:39], s101 offen offset:256 nt
    s_waitcnt vmcnt(2)
    buffer_load_dwordx4 v[48:51], v3, s[40:43], s98 offen offset:0 nt
    s_waitcnt vmcnt(2)
    buffer_load_dwordx4 v[52:55], v3, s[40:43], s98 offen offset:256 nt
    s_waitcnt vmcnt(2)
    buffer_load_dwordx4 v[56:59], v3, s[40:43], s99 offen offset:0 nt
    s_waitcnt vmcnt(2)
    buffer_load_dwordx4 v[60:63], v3, s[40:43], s99 offen offset:256 nt
    s_barrier
    ds_read_b128 v[8:11], v105 offset:29696
    ds_read_b128 v[12:15], v105 offset:29952
    ds_read_b96 v[108:110], v107 offset:47888
    ds_read_b32 v87, v107 offset:47900
    s_waitcnt lgkmcnt(2)
    v_mfma_f32_16x16x32_bf16 v[88:91], v[16:19], v[8:11], 0
    v_mfma_f32_16x16x32_bf16 v[88:91], v[20:23], v[12:15], v[88:91]
    v_mfma_f32_16x16x32_bf16 v[92:95], v[24:27], v[8:11], 0
    v_mfma_f32_16x16x32_bf16 v[92:95], v[28:31], v[12:15], v[92:95]
    v_mfma_f32_16x16x32_bf16 v[96:99], v[32:35], v[8:11], 0
    v_mfma_f32_16x16x32_bf16 v[96:99], v[36:39], v[12:15], v[96:99]
    v_mfma_f32_16x16x32_bf16 v[100:103], v[40:43], v[8:11], 0
    v_mfma_f32_16x16x32_bf16 v[100:103], v[44:47], v[12:15], v[100:103]
    s_waitcnt lgkmcnt(0)
    v_readfirstlane_b32 s57, v110
    v_readfirstlane_b32 s67, v87
    v_mov_b32 v107, 0x3ff
    v_mov_b32_dpp v80, v88 quad_perm:[0,0,0,0] row_mask:0xf bank_mask:0xf
    v_mov_b32_dpp v81, v92 quad_perm:[0,0,0,0] row_mask:0xf bank_mask:0xf
    s_nop 0
    v_mov_b32_dpp v82, v96 quad_perm:[0,0,0,0] row_mask:0xf bank_mask:0xf
    s_nop 0
    v_mov_b32_dpp v83, v100 quad_perm:[0,0,0,0] row_mask:0xf bank_mask:0xf
    v_add_f32_dpp v80, v89, v80 quad_perm:[1,1,1,1] row_mask:0xf bank_mask:0xf
    v_add_f32_dpp v81, v93, v81 quad_perm:[1,1,1,1] row_mask:0xf bank_mask:0xf
    v_add_f32_dpp v82, v97, v82 quad_perm:[1,1,1,1] row_mask:0xf bank_mask:0xf
    v_add_f32_dpp v83, v101, v83 quad_perm:[1,1,1,1] row_mask:0xf bank_mask:0xf
    v_add_f32_dpp v80, v90, v80 quad_perm:[2,2,2,2] row_mask:0xf bank_mask:0xf
    v_add_f32_dpp v81, v94, v81 quad_perm:[2,2,2,2] row_mask:0xf bank_mask:0xf
    v_add_f32_dpp v82, v98, v82 quad_perm:[2,2,2,2] row_mask:0xf bank_mask:0xf
    v_add_f32_dpp v83, v102, v83 quad_perm:[2,2,2,2] row_mask:0xf bank_mask:0xf
    v_add_f32_dpp v80, v91, v80 quad_perm:[3,3,3,3] row_mask:0xf bank_mask:0xf
    v_add_f32_dpp v81, v95, v81 quad_perm:[3,3,3,3] row_mask:0xf bank_mask:0xf
    v_add_f32_dpp v82, v99, v82 quad_perm:[3,3,3,3] row_mask:0xf bank_mask:0xf
    v_add_f32_dpp v83, v103, v83 quad_perm:[3,3,3,3] row_mask:0xf bank_mask:0xf
    v_cvt_pk_bf16_f32 v80, v80, v80
    v_cvt_pk_bf16_f32 v81, v81, v81
    v_cvt_pk_bf16_f32 v82, v82, v82
    v_cvt_pk_bf16_f32 v83, v83, v83
    v_and_b32 v80, 0xffff0000, v80
    v_and_b32 v81, 0xffff0000, v81
    v_and_b32 v82, 0xffff0000, v82
    v_and_b32 v83, 0xffff0000, v83
    v_max3_f32 v84, v80, v81, v82
    v_max_f32 v84, v84, v83
    s_mov_b64 exec, s[60:61]
    ds_max_f32 v106, v84 offset:47616
    s_mov_b64 exec, -1
    s_and_b32 s58, s57, 0x3ff
    s_waitcnt vmcnt(2)
    buffer_load_dwordx4 v[64:67], v3, s[40:43], s100 offen offset:0 nt
    s_waitcnt lgkmcnt(0)
    s_barrier
    ds_read_b32 v84, v106 offset:47616
    s_waitcnt lgkmcnt(0)
    v_mul_f32 v84, s59, v84
    v_fma_f32 v80, v80, s59, -v84
    v_fma_f32 v81, v81, s59, -v84
    v_fma_f32 v82, v82, s59, -v84
    v_fma_f32 v83, v83, s59, -v84
    v_exp_f32 v80, v80
    v_exp_f32 v81, v81
    v_exp_f32 v82, v82
    v_exp_f32 v83, v83
    s_nop 0
    v_add_f32 v84, v80, v81
    v_add_f32 v85, v82, v83
    v_add_f32 v84, v84, v85
    s_mov_b64 exec, s[60:61]
    ds_write_b32 v136, v84 offset:47632
    s_mov_b64 exec, -1
    s_waitcnt vmcnt(2)
    buffer_load_dwordx4 v[68:71], v3, s[40:43], s100 offen offset:256 nt
    v_cvt_pk_bf16_f32 v80, v80, v80
    v_cvt_pk_bf16_f32 v81, v81, v81
    v_cvt_pk_bf16_f32 v82, v82, v82
    v_cvt_pk_bf16_f32 v83, v83, v83
    s_waitcnt lgkmcnt(0)
    s_barrier
    v_and_b32 v16, v80, v4
    v_and_b32 v17, v80, v5
    v_and_b32 v18, v80, v6
    v_and_b32 v19, v80, v7
    v_and_b32 v20, v81, v4
    v_and_b32 v21, v81, v5
    v_and_b32 v22, v81, v6
    v_and_b32 v23, v81, v7
    v_and_b32 v24, v82, v4
    v_and_b32 v25, v82, v5
    v_and_b32 v26, v82, v6
    v_and_b32 v27, v82, v7
    v_and_b32 v28, v83, v4
    v_and_b32 v29, v83, v5
    v_and_b32 v30, v83, v6
    v_and_b32 v31, v83, v7
    s_waitcnt vmcnt(2)
    buffer_load_dwordx4 v[72:75], v3, s[40:43], s101 offen offset:0 nt
    s_waitcnt vmcnt(2)
    buffer_load_dwordx4 v[76:79], v3, s[40:43], s101 offen offset:256 nt
    s_cmp_ge_u32 s30, 4
    s_cbranch_scc1 L_pvhi
    s_waitcnt vmcnt(6)
    v_mfma_f32_16x16x32_bf16 v[32:35], v[16:19], v[48:51], 0
    v_mfma_f32_16x16x32_bf16 v[36:39], v[16:19], v[52:55], 0
    s_waitcnt vmcnt(4)
    v_mfma_f32_16x16x32_bf16 v[32:35], v[20:23], v[56:59], v[32:35]
    v_mfma_f32_16x16x32_bf16 v[36:39], v[20:23], v[60:63], v[36:39]
    s_waitcnt vmcnt(2)
    s_barrier
    v_mfma_f32_16x16x32_bf16 v[32:35], v[24:27], v[64:67], v[32:35]
    v_mfma_f32_16x16x32_bf16 v[36:39], v[24:27], v[68:71], v[36:39]
    buffer_load_dwordx4 v[112:115], v104, s[52:55], 0 offen offset:0 nt
    buffer_load_dwordx4 v[116:119], v104, s[52:55], 0 offen offset:3584 nt
    buffer_load_dwordx4 v[120:123], v104, s[48:51], 0 offen offset:0 nt
    buffer_load_dwordx4 v[124:127], v104, s[48:51], 0 offen offset:3584 nt
    buffer_load_dwordx4 v[128:131], v104, s[48:51], s69 offen offset:0 nt
    buffer_load_dwordx4 v[132:135], v104, s[48:51], s69 offen offset:3584 nt
    s_waitcnt vmcnt(7)
    v_mfma_f32_16x16x32_bf16 v[32:35], v[28:31], v[72:75], v[32:35]
    s_nop 7
    ds_write_b128 v137, v[32:35] offset:30720
    s_waitcnt vmcnt(6)
    v_mfma_f32_16x16x32_bf16 v[36:39], v[28:31], v[76:79], v[36:39]
    s_branch L_pvdone
L_pvhi:
    s_waitcnt vmcnt(6)
    v_mfma_f32_16x16x32_bf16 v[32:35], v[16:19], v[48:51], 0
    v_mfma_f32_16x16x32_bf16 v[36:39], v[16:19], v[52:55], 0
    s_waitcnt vmcnt(4)
    v_mfma_f32_16x16x32_bf16 v[32:35], v[20:23], v[56:59], v[32:35]
    v_mfma_f32_16x16x32_bf16 v[36:39], v[20:23], v[60:63], v[36:39]
    s_waitcnt vmcnt(2)
    s_barrier
    v_mfma_f32_16x16x32_bf16 v[32:35], v[24:27], v[64:67], v[32:35]
    v_mfma_f32_16x16x32_bf16 v[36:39], v[24:27], v[68:71], v[36:39]
    s_waitcnt vmcnt(1)
    v_mfma_f32_16x16x32_bf16 v[32:35], v[28:31], v[72:75], v[32:35]
    s_nop 7
    ds_write_b128 v137, v[32:35] offset:30720
    s_waitcnt vmcnt(0)
    v_mfma_f32_16x16x32_bf16 v[36:39], v[28:31], v[76:79], v[36:39]
L_pvdone:
    s_nop 7
    ds_write_b128 v137, v[36:39] offset:31232
    s_waitcnt lgkmcnt(0)
    s_barrier
    ds_read2st64_b32 v[16:17], v138 offset0:0 offset1:8
    ds_read2st64_b32 v[18:19], v138 offset0:16 offset1:24
    ds_read2st64_b32 v[20:21], v138 offset0:32 offset1:40
    ds_read2st64_b32 v[22:23], v138 offset0:48 offset1:56
    ds_read_b64 v[56:57], v141 offset:48224
    s_cmp_lg_u32 s67, 0
    s_waitcnt lgkmcnt(3)
    v_add_f32 v16, v16, v17
    v_add_f32 v18, v18, v19
    s_waitcnt lgkmcnt(1)
    v_add_f32 v20, v20, v21
    v_add_f32 v22, v22, v23
    v_add_f32 v16, v16, v18
    v_add_f32 v20, v20, v22
    v_add_f32 v16, v16, v20
    v_bfi_b32 v16, v107, s58, v16
    s_cbranch_scc1 L_st1far
    buffer_store_dword v16, v139, s[44:47], s34 offen
    s_branch L_st1done
L_st1far:
    buffer_store_dword v16, v139, s[44:47], s34 offen sc1
L_st1done:
    s_cmp_ge_u32 s30, 4
    s_cbranch_scc1 L_kv_hi
    s_waitcnt lgkmcnt(0)
    v_and_b32 v20, v56, v4
    v_and_b32 v21, v56, v5
    v_and_b32 v22, v56, v6
    v_and_b32 v23, v56, v7
    v_and_b32 v24, v57, v4
    v_and_b32 v25, v57, v5
    v_and_b32 v26, v57, v6
    v_and_b32 v27, v57, v7
    s_waitcnt vmcnt(5)
    v_mfma_f32_16x16x32_bf16 v[36:39], v[20:23], v[112:115], 0
    v_mfma_f32_16x16x32_bf16 v[36:39], v[24:27], v[116:119], v[36:39]
    s_waitcnt vmcnt(1)
    s_nop 6
    v_mul_f32 v36, v109, v36
    v_mul_f32 v37, v109, v37
    v_mul_f32 v38, v109, v38
    v_mul_f32 v39, v109, v39
    s_barrier
    ds_read_b128 v[48:51], v141 offset:48160
    s_waitcnt vmcnt(0) lgkmcnt(0)
    v_and_b32 v52, v48, v4
    v_and_b32 v53, v48, v5
    v_and_b32 v54, v48, v6
    v_and_b32 v55, v48, v7
    v_and_b32 v56, v49, v4
    v_and_b32 v57, v49, v5
    v_and_b32 v58, v49, v6
    v_and_b32 v59, v49, v7
    v_mfma_f32_16x16x32_bf16 v[32:35], v[52:55], v[120:123], 0
    v_and_b32 v60, v50, v4
    v_and_b32 v61, v50, v5
    v_and_b32 v62, v50, v6
    v_and_b32 v63, v50, v7
    v_mfma_f32_16x16x32_bf16 v[32:35], v[56:59], v[124:127], v[32:35]
    v_and_b32 v64, v51, v4
    v_and_b32 v65, v51, v5
    v_and_b32 v66, v51, v6
    v_and_b32 v67, v51, v7
    v_mfma_f32_16x16x32_bf16 v[32:35], v[60:63], v[128:131], v[32:35]
    s_nop 0
    v_mfma_f32_16x16x32_bf16 v[32:35], v[64:67], v[132:135], v[32:35]
    s_mov_b32 exec_hi, 0
    s_nop 6
    v_fmac_f32 v36, v108, v32
    v_fmac_f32 v37, v108, v33
    v_fmac_f32 v38, v108, v34
    v_fmac_f32 v39, v108, v35
    v_bfi_b32 v36, v107, s58, v36
    v_bfi_b32 v37, v107, s58, v37
    v_bfi_b32 v38, v107, s58, v38
    v_bfi_b32 v39, v107, s58, v39
    buffer_store_dwordx4 v[36:39], v140, s[44:47], s3 offen sc1
    s_mov_b64 exec, -1
    s_branch L_hop2
L_kv_hi:
    s_barrier
L_hop2:
    s_cmp_eq_u32 s31, 7
    s_cbranch_scc1 L_fin
    s_cmp_ge_u32 s32, 8
    s_cbranch_scc1 L_fin
    s_lshl_b32 s35, s31, 3
    s_add_u32 s35, s35, s32
    v_lshrrev_b32 v25, 1, v0
    v_lshlrev_b32 v25, 11, v25
    v_and_b32 v26, 1, v0
    v_lshl_add_u32 v25, v26, 4, v25
    s_lshl_b32 s34, s35, 5
    s_add_u32 s34, s34, 786432
    s_mov_b32 s68, 0
    s_waitcnt vmcnt(0)
    s_barrier
L_p2:
    buffer_load_dwordx4 v[28:31], v25, s[44:47], s34 offen sc1
    s_add_u32 s68, s68, 1
    s_waitcnt vmcnt(0)
    v_xor_b32 v16, s58, v28
    v_xor_b32 v17, s58, v29
    v_xor_b32 v18, s58, v30
    v_xor_b32 v19, s58, v31
    v_or3_b32 v20, v16, v17, v18
    v_bitop3_b32 v20, v20, v19, v107 bitop3:0xa8
    v_cmp_ne_u32 vcc, 0, v20
    s_and_b64 exec, exec, vcc
    s_cbranch_execz L_p2ok
    s_cmp_lt_u32 s68, 4000000
    s_cbranch_scc1 L_p2
L_p2ok:
    s_mov_b64 exec, -1
    v_add_f32_dpp v16, v16, v16 quad_perm:[2,3,0,1] row_mask:0xf bank_mask:0xf
    v_add_f32_dpp v17, v17, v17 quad_perm:[2,3,0,1] row_mask:0xf bank_mask:0xf
    v_add_f32_dpp v18, v18, v18 quad_perm:[2,3,0,1] row_mask:0xf bank_mask:0xf
    v_add_f32_dpp v19, v19, v19 quad_perm:[2,3,0,1] row_mask:0xf bank_mask:0xf
    v_add_f32_dpp v16, v16, v16 row_ror:4 row_mask:0xf bank_mask:0xf
    v_add_f32_dpp v17, v17, v17 row_ror:4 row_mask:0xf bank_mask:0xf
    v_add_f32_dpp v18, v18, v18 row_ror:4 row_mask:0xf bank_mask:0xf
    v_add_f32_dpp v19, v19, v19 row_ror:4 row_mask:0xf bank_mask:0xf
    v_add_f32_dpp v16, v16, v16 row_ror:8 row_mask:0xf bank_mask:0xf
    v_add_f32_dpp v17, v17, v17 row_ror:8 row_mask:0xf bank_mask:0xf
    v_add_f32_dpp v18, v18, v18 row_ror:8 row_mask:0xf bank_mask:0xf
    v_add_f32_dpp v19, v19, v19 row_ror:8 row_mask:0xf bank_mask:0xf
    v_lshrrev_b32 v27, 4, v1
    v_lshl_add_u32 v27, v26, 2, v27
    v_permlane16_swap_b32 v16, v17
    v_permlane16_swap_b32 v18, v19
    v_lshlrev_b32 v27, 5, v27
    v_add_f32 v16, v16, v17
    v_add_f32 v18, v18, v19
    s_lshl_b32 s64, s30, 2
    v_add_u32 v27, s64, v27
    v_permlane32_swap_b32 v16, v18
    s_mov_b32 s62, 0x00030003
    s_mov_b32 s63, 0x00030003
    v_add_f32 v16, v16, v18
    s_mov_b64 exec, s[62:63]
    ds_write_b32 v27, v16 offset:47904
    s_mov_b64 exec, -1
    v_lshlrev_b32 v27, 5, v1
    s_waitcnt lgkmcnt(0)
    s_barrier
    s_cmp_lg_u32 s30, 0
    s_cbranch_scc1 L_fin
    s_mov_b64 exec, 0xff
    ds_read_b128 v[16:19], v27 offset:47904
    ds_read_b128 v[20:23], v27 offset:47920
    s_mov_b32 s48, s24
    s_mov_b32 s49, s25
    s_movk_i32 s50, 896
    s_mov_b32 s51, 0x20000
    s_lshl_b32 s34, s35, 4
    v_lshlrev_b32 v27, 1, v1
    s_waitcnt lgkmcnt(0)
    v_add_f32 v16, v16, v20
    v_add_f32 v17, v17, v21
    v_add_f32 v18, v18, v22
    v_add_f32 v19, v19, v23
    v_add_f32 v16, v16, v17
    v_add_f32 v18, v18, v19
    v_add_f32 v16, v16, v18
    v_cvt_pk_bf16_f32 v16, v16, v16
    buffer_store_short v16, v27, s[48:51], s34 offen
    s_cmp_lg_u32 s35, 0
    s_cbranch_scc1 L_fin
    s_mov_b64 exec, 1
    v_mov_b32 v17, s57
    v_mov_b32 v18, 0
    buffer_store_dword v17, v18, s[44:47], 0 offen
L_fin:
    s_endpgm
L_helper:
    s_setprio 3
    v_lshlrev_b32 v2, 4, v1
    s_mov_b32 s40, s4
    s_mov_b32 s41, s5
    s_movk_i32 s42, 896
    s_mov_b32 s43, 0x20000
    s_mov_b32 s48, s22
    s_mov_b32 s49, s23
    s_movk_i32 s50, 896
    s_mov_b32 s51, 0x20000
    buffer_load_dwordx4 v[16:19], v2, s[48:51], 0 offen
    v_mov_b32 v6, 0xff800000
    v_mov_b32 v7, 0xff800000
    v_mov_b32 v4, 0
    ds_write_b64 v4, v[6:7] offset:47616
    s_mov_b32 s44, s28
    s_mov_b32 s45, s29
    s_mov_b32 s46, 1310720
    s_mov_b32 s47, 0x20000
    s_mov_b32 s55, 0x20000
    s_lshr_b32 s56, s32, 3
    s_bfe_u32 s61, s32, 0x20001
    v_lshlrev_b32 v23, 3, v1
    v_lshrrev_b32 v20, 4, v1
    s_mul_i32 s35, s56, 224
    v_lshlrev_b32 v9, 4, v20
    v_add_u32 v9, s35, v9
    v_lshlrev_b32 v11, 3, v20
    v_add_u32 v11, s35, v11
    v_bfe_u32 v22, v1, 2, 2
    v_and_b32 v21, 3, v1
    v_lshlrev_b32 v8, 2, v21
    v_lshl_add_u32 v8, v20, 4, v8
    v_lshlrev_b32 v21, 3, v21
    v_lshl_add_u32 v21, v22, 7, v21
    v_lshl_add_u32 v10, v20, 10, v21
    v_lshl_add_u32 v21, v20, 9, v21
    v_lshlrev_b32 v38, 2, v1
    v_mov_b32 v39, 0x3ff
    s_mov_b32 s64, 0xffff0000
    s_mov_b32 s65, 0xffff0000
    s_mov_b32 s66, 0
    s_mov_b32 s67, -1
    s_waitcnt lgkmcnt(0)
    s_add_u32 s57, s57, 1
    s_and_b32 s58, s57, 0x3ff
    s_and_b32 s59, s32, 7
    v_xor_b32 v121, 0, v2
    s_lshl_b32 s34, s31, 13
    s_lshl_b32 s35, s56, 11
    s_add_u32 s34, s34, s35
    s_lshl_b32 s35, s59, 8
    s_add_u32 s34, s34, s35
    s_add_u32 s34, s34, 65536
    s_getreg_b32 s68, hwreg(HW_REG_XCC_ID, 0, 4)
    s_lshl_b32 s68, s68, 16
    s_or_b32 s68, s68, s58
    v_mov_b32 v7, s68
    s_lshl_b32 s36, s33, 2
    s_add_u32 s36, s36, 4096
    s_barrier
    ds_read_b128 v[24:27], v9 offset:0
    ds_read_b128 v[28:31], v9 offset:64
    ds_read_b128 v[32:35], v9 offset:128
    ds_read_b64 v[36:37], v11 offset:192
    ds_read_b128 v[12:15], v2 offset:0
    ds_read_b64_tr_b16 v[88:89], v10 offset:1024
    ds_read_b64_tr_b16 v[90:91], v10 offset:1536
    ds_read_b64_tr_b16 v[92:93], v10 offset:1056
    ds_read_b64_tr_b16 v[94:95], v10 offset:1568
    ds_read_b64_tr_b16 v[96:97], v10 offset:1088
    ds_read_b64_tr_b16 v[98:99], v10 offset:1600
    ds_read_b64_tr_b16 v[100:101], v10 offset:1120
    ds_read_b64_tr_b16 v[102:103], v10 offset:1632
    ds_read_b64_tr_b16 v[104:105], v10 offset:5120
    ds_read_b64_tr_b16 v[106:107], v10 offset:5632
    ds_read_b64_tr_b16 v[108:109], v10 offset:5152
    ds_read_b64_tr_b16 v[110:111], v10 offset:5664
    ds_read_b64_tr_b16 v[112:113], v10 offset:5184
    ds_read_b64_tr_b16 v[114:115], v10 offset:5696
    ds_read_b64_tr_b16 v[116:117], v10 offset:5216
    ds_read_b64_tr_b16 v[118:119], v10 offset:5728
    s_waitcnt lgkmcnt(8)
    v_mfma_f32_16x16x32_bf16 v[40:43], v[24:27], v[88:91], 0
    v_mfma_f32_16x16x32_bf16 v[44:47], v[24:27], v[92:95], 0
    v_mfma_f32_16x16x32_bf16 v[48:51], v[24:27], v[96:99], 0
    v_mfma_f32_16x16x32_bf16 v[52:55], v[24:27], v[100:103], 0
    ds_read_b64_tr_b16 v[88:89], v10 offset:9216
    ds_read_b64_tr_b16 v[90:91], v10 offset:9728
    ds_read_b64_tr_b16 v[92:93], v10 offset:9248
    ds_read_b64_tr_b16 v[94:95], v10 offset:9760
    ds_read_b64_tr_b16 v[96:97], v10 offset:9280
    ds_read_b64_tr_b16 v[98:99], v10 offset:9792
    ds_read_b64_tr_b16 v[100:101], v10 offset:9312
    ds_read_b64_tr_b16 v[102:103], v10 offset:9824
    s_waitcnt lgkmcnt(8)
    v_mfma_f32_16x16x32_bf16 v[40:43], v[28:31], v[104:107], v[40:43]
    v_mfma_f32_16x16x32_bf16 v[44:47], v[28:31], v[108:111], v[44:47]
    v_mfma_f32_16x16x32_bf16 v[48:51], v[28:31], v[112:115], v[48:51]
    v_mfma_f32_16x16x32_bf16 v[52:55], v[28:31], v[116:119], v[52:55]
    ds_read_b64_tr_b16 v[104:105], v21 offset:13312
    ds_read_b64_tr_b16 v[108:109], v21 offset:13344
    ds_read_b64_tr_b16 v[112:113], v21 offset:13376
    ds_read_b64_tr_b16 v[116:117], v21 offset:13408
    s_waitcnt lgkmcnt(4)
    v_mfma_f32_16x16x32_bf16 v[40:43], v[32:35], v[88:91], v[40:43]
    v_mfma_f32_16x16x32_bf16 v[44:47], v[32:35], v[92:95], v[44:47]
    v_mfma_f32_16x16x32_bf16 v[48:51], v[32:35], v[96:99], v[48:51]
    v_mfma_f32_16x16x32_bf16 v[52:55], v[32:35], v[100:103], v[52:55]
    s_waitcnt lgkmcnt(0)
    v_mfma_f32_16x16x16_bf16 v[40:43], v[36:37], v[104:105], v[40:43]
    v_mfma_f32_16x16x16_bf16 v[44:47], v[36:37], v[108:109], v[44:47]
    v_mfma_f32_16x16x16_bf16 v[48:51], v[36:37], v[112:113], v[48:51]
    v_mfma_f32_16x16x16_bf16 v[52:55], v[36:37], v[116:117], v[52:55]
    s_nop 5
    v_cndmask_b32 v40, v40, v44, s[64:65]
    s_nop 0
    v_cndmask_b32 v48, v48, v52, s[64:65]
    v_cndmask_b32 v40, v40, v48, s[66:67]
    v_add_u32 v40, 0x200, v40
    v_bfi_b32 v40, v39, s58, v40
    buffer_store_dword v40, v38, s[44:47], s34 offen sc1
    s_mov_b64 exec, 1
    buffer_store_dword v7, v4, s[44:47], s36 offen sc1
    s_mov_b64 exec, -1
    s_waitcnt vmcnt(2)
    v_mov_b32 v20, 0
    v_lshlrev_b32 v41, 16, v12
    v_and_b32 v42, 0xffff0000, v12
    v_lshlrev_b32 v43, 16, v16
    v_and_b32 v44, 0xffff0000, v16
    v_mul_f32 v41, v41, v43
    v_mul_f32 v42, v42, v44
    v_cvt_pk_bf16_f32 v41, v41, v42
    v_lshlrev_b32 v42, 16, v41
    v_and_b32 v41, 0xffff0000, v41
    v_add_f32 v20, v20, v42
    v_add_f32 v20, v20, v41
    v_lshlrev_b32 v41, 16, v13
    v_and_b32 v42, 0xffff0000, v13
    v_lshlrev_b32 v43, 16, v17
    v_and_b32 v44, 0xffff0000, v17
    v_mul_f32 v41, v41, v43
    v_mul_f32 v42, v42, v44
    v_cvt_pk_bf16_f32 v41, v41, v42
    v_lshlrev_b32 v42, 16, v41
    v_and_b32 v41, 0xffff0000, v41
    v_add_f32 v20, v20, v42
    v_add_f32 v20, v20, v41
    v_lshlrev_b32 v41, 16, v14
    v_and_b32 v42, 0xffff0000, v14
    v_lshlrev_b32 v43, 16, v18
    v_and_b32 v44, 0xffff0000, v18
    v_mul_f32 v41, v41, v43
    v_mul_f32 v42, v42, v44
    v_cvt_pk_bf16_f32 v41, v41, v42
    v_lshlrev_b32 v42, 16, v41
    v_and_b32 v41, 0xffff0000, v41
    v_add_f32 v20, v20, v42
    v_add_f32 v20, v20, v41
    v_lshlrev_b32 v41, 16, v15
    v_and_b32 v42, 0xffff0000, v15
    v_lshlrev_b32 v43, 16, v19
    v_and_b32 v44, 0xffff0000, v19
    v_mul_f32 v41, v41, v43
    v_mul_f32 v42, v42, v44
    v_cvt_pk_bf16_f32 v41, v41, v42
    v_lshlrev_b32 v42, 16, v41
    v_and_b32 v41, 0xffff0000, v41
    v_add_f32 v20, v20, v42
    v_add_f32 v20, v20, v41
    s_nop 1
    v_add_f32_dpp v20, v20, v20 quad_perm:[1,0,3,2] row_mask:0xf bank_mask:0xf
    s_nop 1
    v_add_f32_dpp v20, v20, v20 quad_perm:[2,3,0,1] row_mask:0xf bank_mask:0xf
    s_nop 1
    v_add_f32_dpp v20, v20, v20 row_ror:4 row_mask:0xf bank_mask:0xf
    s_nop 1
    v_add_f32_dpp v20, v20, v20 row_ror:8 row_mask:0xf bank_mask:0xf
    s_nop 1
    v_add_f32_dpp v20, v20, v20 row_bcast:15 row_mask:0xa bank_mask:0xf
    s_nop 1
    v_add_f32_dpp v20, v20, v20 row_bcast:31 row_mask:0xc bank_mask:0xf
    s_nop 0
    v_readlane_b32 s35, v20, 63
    s_lshl_b32 s34, s31, 13
    s_add_u32 s34, s34, 65536
    v_mov_b32 v12, s35
    s_add_u32 s35, s34, 4096
    s_lshl_b32 s69, s31, 7
    s_add_u32 s69, s69, 4096
    v_and_b32 v22, 31, v1
    v_lshlrev_b32 v22, 2, v22
    v_cvt_pk_bf16_f32 v12, v12, v12
    v_and_b32 v12, 0xffff0000, v12
    v_mul_f32 v12, 0xbfb8aa3b, v12
    v_exp_f32 v12, v12
    s_nop 0
    v_add_f32 v12, 1.0, v12
    v_rcp_f32 v12, v12
    s_nop 0
    v_cvt_pk_bf16_f32 v12, v12, v12
    v_and_b32 v12, 0xffff0000, v12
    v_sub_f32 v13, 1.0, v12
    v_cvt_pk_bf16_f32 v13, v13, v13
    v_and_b32 v13, 0xffff0000, v13
    v_mov_b32 v14, s57
    s_barrier
    ds_read_b64_tr_b16 v[88:89], v10 offset:15360
    ds_read_b64_tr_b16 v[90:91], v10 offset:15872
    ds_read_b64_tr_b16 v[92:93], v10 offset:15392
    ds_read_b64_tr_b16 v[94:95], v10 offset:15904
    ds_read_b64_tr_b16 v[96:97], v10 offset:15424
    ds_read_b64_tr_b16 v[98:99], v10 offset:15936
    ds_read_b64_tr_b16 v[100:101], v10 offset:15456
    ds_read_b64_tr_b16 v[102:103], v10 offset:15968
    ds_read_b64_tr_b16 v[104:105], v10 offset:19456
    ds_read_b64_tr_b16 v[106:107], v10 offset:19968
    ds_read_b64_tr_b16 v[108:109], v10 offset:19488
    ds_read_b64_tr_b16 v[110:111], v10 offset:20000
    ds_read_b64_tr_b16 v[112:113], v10 offset:19520
    ds_read_b64_tr_b16 v[114:115], v10 offset:20032
    ds_read_b64_tr_b16 v[116:117], v10 offset:19552
    ds_read_b64_tr_b16 v[118:119], v10 offset:20064
    s_waitcnt lgkmcnt(8)
    v_mfma_f32_16x16x32_bf16 v[40:43], v[24:27], v[88:91], 0
    v_mfma_f32_16x16x32_bf16 v[44:47], v[24:27], v[92:95], 0
    v_mfma_f32_16x16x32_bf16 v[48:51], v[24:27], v[96:99], 0
    v_mfma_f32_16x16x32_bf16 v[52:55], v[24:27], v[100:103], 0
    ds_read_b64_tr_b16 v[88:89], v10 offset:23552
    ds_read_b64_tr_b16 v[90:91], v10 offset:24064
    ds_read_b64_tr_b16 v[92:93], v10 offset:23584
    ds_read_b64_tr_b16 v[94:95], v10 offset:24096
    ds_read_b64_tr_b16 v[96:97], v10 offset:23616
    ds_read_b64_tr_b16 v[98:99], v10 offset:24128
    ds_read_b64_tr_b16 v[100:101], v10 offset:23648
    ds_read_b64_tr_b16 v[102:103], v10 offset:24160
    s_waitcnt lgkmcnt(8)
    v_mfma_f32_16x16x32_bf16 v[40:43], v[28:31], v[104:107], v[40:43]
    v_mfma_f32_16x16x32_bf16 v[44:47], v[28:31], v[108:111], v[44:47]
    v_mfma_f32_16x16x32_bf16 v[48:51], v[28:31], v[112:115], v[48:51]
    v_mfma_f32_16x16x32_bf16 v[52:55], v[28:31], v[116:119], v[52:55]
    ds_read_b64_tr_b16 v[104:105], v21 offset:27648
    ds_read_b64_tr_b16 v[108:109], v21 offset:27680
    ds_read_b64_tr_b16 v[112:113], v21 offset:27712
    ds_read_b64_tr_b16 v[116:117], v21 offset:27744
    s_waitcnt lgkmcnt(4)
    v_mfma_f32_16x16x32_bf16 v[40:43], v[32:35], v[88:91], v[40:43]
    v_mfma_f32_16x16x32_bf16 v[44:47], v[32:35], v[92:95], v[44:47]
    v_mfma_f32_16x16x32_bf16 v[48:51], v[32:35], v[96:99], v[48:51]
    v_mfma_f32_16x16x32_bf16 v[52:55], v[32:35], v[100:103], v[52:55]
    s_waitcnt lgkmcnt(0)
    v_mfma_f32_16x16x16_bf16 v[40:43], v[36:37], v[104:105], v[40:43]
    v_mfma_f32_16x16x16_bf16 v[44:47], v[36:37], v[108:109], v[44:47]
    v_mfma_f32_16x16x16_bf16 v[48:51], v[36:37], v[112:113], v[48:51]
    v_mfma_f32_16x16x16_bf16 v[52:55], v[36:37], v[116:117], v[52:55]
    s_lshl_b32 s3, s31, 13
    s_and_b32 s60, s32, 1
    s_lshl_b32 s60, s60, 12
    s_add_u32 s3, s3, s60
    s_lshl_b32 s60, s56, 10
    s_add_u32 s3, s3, s60
    s_lshl_b32 s60, s61, 8
    s_add_u32 s3, s3, s60
    s_add_u32 s3, s3, 131072
    s_nop 5
    v_cndmask_b32 v40, v40, v44, s[64:65]
    s_nop 0
    v_cndmask_b32 v48, v48, v52, s[64:65]
    v_cndmask_b32 v40, v40, v48, s[66:67]
    v_add_u32 v40, 0x200, v40
    v_bfi_b32 v40, v39, s58, v40
    buffer_store_dword v40, v38, s[44:47], s3 offen sc1
    buffer_load_dwordx4 v[56:59], v121, s[44:47], s34 offen offset:0 sc1
    buffer_load_dwordx4 v[60:63], v121, s[44:47], s34 offen offset:1024 sc1
    buffer_load_dwordx4 v[64:67], v121, s[44:47], s34 offen offset:2048 sc1
    buffer_load_dwordx4 v[68:71], v121, s[44:47], s34 offen offset:3072 sc1
    buffer_load_dwordx4 v[72:75], v121, s[44:47], s35 offen offset:0 sc1
    buffer_load_dwordx4 v[76:79], v121, s[44:47], s35 offen offset:1024 sc1
    buffer_load_dwordx4 v[80:83], v121, s[44:47], s35 offen offset:2048 sc1
    buffer_load_dwordx4 v[84:87], v121, s[44:47], s35 offen offset:3072 sc1
    buffer_load_dword v6, v22, s[44:47], s69 offen sc1
    v_bfe_u32 v20, v1, 3, 1
    v_lshlrev_b32 v122, 12, v20
    v_and_b32 v20, 3, v1
    v_lshl_add_u32 v122, v20, 10, v122
    v_bfe_u32 v20, v1, 2, 1
    v_lshl_add_u32 v122, v20, 4, v122
    v_lshlrev_b32 v20, 2, v20
    s_lshl_b32 s37, s31, 13
    s_lshl_b32 s36, s32, 5
    s_add_u32 s37, s37, s36
    s_add_u32 s37, s37, 131072
    s_lshl_b32 s54, s33, 4
    s_add_u32 s54, s54, 8192
    v_and_b32 v21, 1, v1
    v_lshlrev_b32 v21, 2, v21
    s_nop 0
    v_lshrrev_b32 v10, 2, v1
    v_lshlrev_b32 v9, 11, v10
    v_and_b32 v11, 3, v1
    v_lshl_add_u32 v9, v11, 4, v9
    v_lshlrev_b32 v10, 4, v10
    s_lshl_b32 s65, s31, 16
    s_lshl_b32 s66, s32, 6
    s_add_u32 s65, s65, s66
    s_add_u32 s65, s65, 262144
    s_add_u32 s66, s65, 0x8000
    s_lshl_b32 s64, s31, 9
    s_add_u32 s64, s64, 8192
    s_mov_b32 s59, 0x3db8aa3b
    s_cmp_ge_u32 s32, 16
    s_cselect_b64 s[42:43], -1, 0
    s_mov_b32 s63, 0
    s_waitcnt vmcnt(0)
    s_branch L_pq1
L_pq:
    s_waitcnt vmcnt(0)
L_pq1:
    v_xor_b32 v16, s58, v6
    v_xor_b32 v88, s58, v56
    v_xor_b32 v89, s58, v57
    v_xor_b32 v90, s58, v58
    v_xor_b32 v91, s58, v59
    v_xor_b32 v92, s58, v60
    v_xor_b32 v93, s58, v61
    v_xor_b32 v94, s58, v62
    v_xor_b32 v95, s58, v63
    v_xor_b32 v96, s58, v64
    v_xor_b32 v97, s58, v65
    v_xor_b32 v98, s58, v66
    v_xor_b32 v99, s58, v67
    v_xor_b32 v100, s58, v68
    v_xor_b32 v101, s58, v69
    v_xor_b32 v102, s58, v70
    v_xor_b32 v103, s58, v71
    v_xor_b32 v104, s58, v72
    v_xor_b32 v105, s58, v73
    v_xor_b32 v106, s58, v74
    v_xor_b32 v107, s58, v75
    v_xor_b32 v108, s58, v76
    v_xor_b32 v109, s58, v77
    v_xor_b32 v110, s58, v78
    v_xor_b32 v111, s58, v79
    v_xor_b32 v112, s58, v80
    v_xor_b32 v113, s58, v81
    v_xor_b32 v114, s58, v82
    v_xor_b32 v115, s58, v83
    v_xor_b32 v116, s58, v84
    v_xor_b32 v117, s58, v85
    v_xor_b32 v118, s58, v86
    v_xor_b32 v119, s58, v87
    v_or3_b32 v16, v16, v88, v89
    v_or3_b32 v16, v16, v90, v91
    v_or3_b32 v16, v16, v92, v93
    v_or3_b32 v16, v16, v94, v95
    v_or3_b32 v16, v16, v96, v97
    v_or3_b32 v16, v16, v98, v99
    v_or3_b32 v16, v16, v100, v101
    v_or3_b32 v16, v16, v102, v103
    v_or3_b32 v16, v16, v104, v105
    v_or3_b32 v16, v16, v106, v107
    v_or3_b32 v16, v16, v108, v109
    v_or3_b32 v16, v16, v110, v111
    v_or3_b32 v16, v16, v112, v113
    v_or3_b32 v16, v16, v114, v115
    v_or3_b32 v16, v16, v116, v117
    v_or3_b32 v16, v16, v118, v119
    v_and_b32 v16, v16, v39
    v_cmp_ne_u32 vcc, 0, v16
    s_cbranch_vccz L_pqok
    s_add_u32 s63, s63, 1
    s_cmp_ge_u32 s63, 4000000
    s_cbranch_scc1 L_pqok
    buffer_load_dwordx4 v[56:59], v121, s[44:47], s34 offen offset:0 sc1
    buffer_load_dwordx4 v[60:63], v121, s[44:47], s34 offen offset:1024 sc1
    buffer_load_dwordx4 v[64:67], v121, s[44:47], s34 offen offset:2048 sc1
    buffer_load_dwordx4 v[68:71], v121, s[44:47], s34 offen offset:3072 sc1
    buffer_load_dwordx4 v[72:75], v121, s[44:47], s35 offen offset:0 sc1
    buffer_load_dwordx4 v[76:79], v121, s[44:47], s35 offen offset:1024 sc1
    buffer_load_dwordx4 v[80:83], v121, s[44:47], s35 offen offset:2048 sc1
    buffer_load_dwordx4 v[84:87], v121, s[44:47], s35 offen offset:3072 sc1
    buffer_load_dword v6, v22, s[44:47], s69 offen sc1
    s_branch L_pq
L_pqok:
    v_add_f32 v56, v88, v96
    v_add_f32 v72, v104, v112
    v_add_f32 v56, v56, v72
    v_add_f32 v57, v89, v97
    v_add_f32 v73, v105, v113
    v_add_f32 v57, v57, v73
    v_add_f32 v58, v90, v98
    v_add_f32 v74, v106, v114
    v_add_f32 v58, v58, v74
    v_add_f32 v59, v91, v99
    v_add_f32 v75, v107, v115
    v_add_f32 v59, v59, v75
    v_add_f32 v60, v92, v100
    v_add_f32 v76, v108, v116
    v_add_f32 v60, v60, v76
    v_add_f32 v61, v93, v101
    v_add_f32 v77, v109, v117
    v_add_f32 v61, v61, v77
    v_add_f32 v62, v94, v102
    v_add_f32 v78, v110, v118
    v_add_f32 v62, v62, v78
    v_add_f32 v63, v95, v103
    v_add_f32 v79, v111, v119
    v_add_f32 v63, v63, v79
    v_cvt_pk_bf16_f32 v56, v56, v57
    v_cvt_pk_bf16_f32 v57, v58, v59
    v_cvt_pk_bf16_f32 v58, v60, v61
    v_cvt_pk_bf16_f32 v59, v62, v63
    ds_write_b64 v23, v[56:57] offset:29696
    ds_write_b64 v23, v[58:59] offset:30208
    v_cmp_ne_u32 vcc, s68, v6
    s_cmp_lg_u64 vcc, 0
    s_cselect_b32 s60, 1, 0
    v_mov_b32 v15, s60
    ds_write_b128 v4, v[12:15] offset:47888
    buffer_load_dwordx4 v[24:27], v122, s[44:47], s37 offen sc1
    s_mov_b32 s63, 0
    s_waitcnt lgkmcnt(0)
    s_barrier
    s_barrier
    s_barrier
    ds_read_b32 v17, v38 offset:47632
    ds_read_b32 v16, v21 offset:47616
    s_cmp_lg_u32 s60, 0
    s_waitcnt lgkmcnt(0)
    v_add_f32_dpp v17, v17, v17 quad_perm:[2,3,0,1] row_mask:0xf bank_mask:0xf
    s_nop 1
    v_add_f32_dpp v17, v17, v17 row_ror:4 row_mask:0xf bank_mask:0xf
    s_nop 1
    v_add_f32_dpp v17, v17, v17 row_ror:8 row_mask:0xf bank_mask:0xf
    s_nop 1
    v_mov_b32 v18, v17
    v_bfi_b32 v16, v39, s58, v16
    s_nop 0
    v_permlane16_swap_b32 v17, v18
    v_add_f32 v17, v17, v18
    v_mov_b32 v18, v17
    s_nop 1
    v_permlane32_swap_b32 v17, v18
    v_add_f32 v17, v17, v18
    v_bfi_b32 v17, v39, s58, v17
    s_mov_b64 exec, 3
    s_cbranch_scc1 L_stsfar
    buffer_store_dwordx2 v[16:17], v23, s[44:47], s54 offen
    s_branch L_stsdone
L_stsfar:
    buffer_store_dwordx2 v[16:17], v23, s[44:47], s54 offen sc1
L_stsdone:
    s_mov_b64 exec, -1
    s_and_b32 s38, s32, 15
    s_lshl_b32 s38, s38, 2
    s_lshl_b64 s[38:39], 15, s38
    v_readlane_b32 s40, v16, 0
    v_readlane_b32 s41, v17, 0
    v_readlane_b32 s48, v16, 1
    v_readlane_b32 s49, v17, 1
    s_waitcnt vmcnt(1)
    s_branch L_pg1
L_pg:
    s_waitcnt vmcnt(0)
L_pg1:
    v_bitop3_b32 v17, v24, v25, s58 bitop3:0x7e
    v_bitop3_b32 v18, v26, v27, s58 bitop3:0x7e
    v_bitop3_b32 v17, v17, v18, v39 bitop3:0xa8
    v_cmp_ne_u32 vcc, 0, v17
    s_cbranch_vccz L_pgok
    s_add_u32 s63, s63, 1
    s_cmp_ge_u32 s63, 4000000
    s_cbranch_scc1 L_pgok
    buffer_load_dwordx4 v[24:27], v122, s[44:47], s37 offen sc1
    s_branch L_pg
L_pgok:
    v_and_b32 v24, 0xfffffc00, v24
    v_and_b32 v25, 0xfffffc00, v25
    v_and_b32 v26, 0xfffffc00, v26
    v_and_b32 v27, 0xfffffc00, v27
    v_add_f32_dpp v24, v24, v24 quad_perm:[1,0,3,2] row_mask:0xf bank_mask:0xf
    v_add_f32_dpp v25, v25, v25 quad_perm:[1,0,3,2] row_mask:0xf bank_mask:0xf
    v_add_f32_dpp v26, v26, v26 quad_perm:[1,0,3,2] row_mask:0xf bank_mask:0xf
    v_add_f32_dpp v27, v27, v27 quad_perm:[1,0,3,2] row_mask:0xf bank_mask:0xf
    v_add_f32_dpp v24, v24, v24 quad_perm:[2,3,0,1] row_mask:0xf bank_mask:0xf
    v_add_f32_dpp v25, v25, v25 quad_perm:[2,3,0,1] row_mask:0xf bank_mask:0xf
    v_add_f32_dpp v26, v26, v26 quad_perm:[2,3,0,1] row_mask:0xf bank_mask:0xf
    v_add_f32_dpp v27, v27, v27 quad_perm:[2,3,0,1] row_mask:0xf bank_mask:0xf
    v_cvt_pk_bf16_f32 v24, v24, v24
    v_cvt_pk_bf16_f32 v25, v25, v25
    v_cvt_pk_bf16_f32 v26, v26, v26
    v_cvt_pk_bf16_f32 v27, v27, v27
    v_and_b32 v24, 0xffff0000, v24
    v_and_b32 v25, 0xffff0000, v25
    v_and_b32 v26, 0xffff0000, v26
    v_and_b32 v27, 0xffff0000, v27
    v_mul_f32 v28, 0xbfb8aa3b, v24
    v_mul_f32 v29, 0xbfb8aa3b, v25
    v_mul_f32 v30, 0xbfb8aa3b, v26
    v_mul_f32 v31, 0xbfb8aa3b, v27
    v_exp_f32 v28, v28
    v_exp_f32 v29, v29
    v_exp_f32 v30, v30
    v_exp_f32 v31, v31
    v_mov_b32_dpp v32, v24 row_ror:8 row_mask:0xf bank_mask:0xf
    v_mov_b32_dpp v33, v25 row_ror:8 row_mask:0xf bank_mask:0xf
    v_mov_b32_dpp v34, v26 row_ror:8 row_mask:0xf bank_mask:0xf
    v_mov_b32_dpp v35, v27 row_ror:8 row_mask:0xf bank_mask:0xf
    v_add_f32 v28, 1.0, v28
    v_add_f32 v29, 1.0, v29
    v_add_f32 v30, 1.0, v30
    v_add_f32 v31, 1.0, v31
    v_rcp_f32 v28, v28
    v_rcp_f32 v29, v29
    v_rcp_f32 v30, v30
    v_rcp_f32 v31, v31
    v_mul_f32 v28, v24, v28
    v_mul_f32 v29, v25, v29
    v_mul_f32 v30, v26, v30
    v_mul_f32 v31, v27, v31
    v_cvt_pk_bf16_f32 v28, v28, v28
    v_cvt_pk_bf16_f32 v29, v29, v29
    v_cvt_pk_bf16_f32 v30, v30, v30
    v_cvt_pk_bf16_f32 v31, v31, v31
    v_and_b32 v28, 0xffff0000, v28
    v_and_b32 v29, 0xffff0000, v29
    v_and_b32 v30, 0xffff0000, v30
    v_and_b32 v31, 0xffff0000, v31
    v_mul_f32 v28, v28, v32
    v_mul_f32 v29, v29, v33
    v_mul_f32 v30, v30, v34
    v_mul_f32 v31, v31, v35
    v_cvt_pk_bf16_f32 v28, v28, v28
    v_cvt_pk_bf16_f32 v29, v29, v29
    v_cvt_pk_bf16_f32 v30, v30, v30
    v_cvt_pk_bf16_f32 v31, v31, v31
    s_mov_b64 exec, 0x11
    ds_write_b32 v20, v28 offset:48224
    ds_write_b32 v20, v29 offset:48240
    ds_write_b32 v20, v30 offset:48256
    ds_write_b32 v20, v31 offset:48272
    s_mov_b64 exec, -1
L_hdone:
    s_mov_b64 exec, -1
    s_mov_b32 s63, 0
    buffer_load_dwordx4 v[72:75], v9, s[44:47], s65 offen sc1
    buffer_load_dwordx4 v[76:79], v9, s[44:47], s66 offen sc1
    s_barrier
    buffer_load_dwordx4 v[56:59], v10, s[44:47], s64 offen sc1
    buffer_load_dwordx4 v[60:63], v10, s[44:47], s64 offen offset:256 sc1
    s_waitcnt lgkmcnt(0)
    s_barrier
    s_mov_b32 s61, 0
    s_waitcnt vmcnt(0)
    s_mov_b64 exec, s[38:39]
    s_cmp_ge_u32 s32, 16
    s_cbranch_scc1 L_ownhi
    v_mov_b32 v56, s40
    v_mov_b32 v57, s41
    v_mov_b32 v58, s48
    v_mov_b32 v59, s49
    s_mov_b64 exec, -1
    s_branch L_ps2
L_ownhi:
    v_mov_b32 v60, s40
    v_mov_b32 v61, s41
    v_mov_b32 v62, s48
    v_mov_b32 v63, s49
    s_mov_b64 exec, -1
    s_branch L_ps2
L_ps:
    buffer_load_dwordx4 v[56:59], v10, s[44:47], s64 offen sc1
    buffer_load_dwordx4 v[60:63], v10, s[44:47], s64 offen offset:256 sc1
    s_mov_b64 s[36:37], exec
    s_mov_b64 exec, -1
    buffer_load_dwordx4 v[48:51], v9, s[44:47], s65 offen sc1
    buffer_load_dwordx4 v[52:55], v9, s[44:47], s66 offen sc1
    s_mov_b64 exec, s[36:37]
    s_mov_b32 s61, 1
L_ps1:
    s_add_u32 s63, s63, 1
    s_waitcnt vmcnt(0)
L_ps2:
    v_bitop3_b32 v17, v56, v57, s58 bitop3:0x7e
    v_bitop3_b32 v18, v58, v59, s58 bitop3:0x7e
    v_bitop3_b32 v19, v60, v61, s58 bitop3:0x7e
    v_bitop3_b32 v16, v62, v63, s58 bitop3:0x7e
    v_or3_b32 v17, v17, v18, v19
    v_bitop3_b32 v17, v17, v16, v39 bitop3:0xa8
    v_cmp_ne_u32 vcc, 0, v17
    s_and_b64 exec, exec, vcc
    s_cbranch_execz L_psok
    s_cmp_lt_u32 s63, 4000000
    s_cbranch_scc1 L_ps
L_psok:
    s_mov_b64 exec, -1
    s_mov_b64 s[36:37], -1
    s_cmp_eq_u32 s61, 0
    s_cbranch_scc1 L_po0
    v_xor_b32 v64, s58, v48
    v_xor_b32 v65, s58, v49
    v_xor_b32 v66, s58, v50
    v_xor_b32 v67, s58, v51
    v_or3_b32 v17, v64, v65, v66
    v_xor_b32 v68, s58, v52
    v_xor_b32 v69, s58, v53
    v_xor_b32 v70, s58, v54
    v_xor_b32 v71, s58, v55
    v_or3_b32 v17, v17, v67, v68
    v_or3_b32 v17, v17, v69, v70
    v_bitop3_b32 v17, v17, v71, v39 bitop3:0xa8
    v_cmp_ne_u32 vcc, 0, v17
    s_and_b64 s[36:37], vcc, vcc
    s_cbranch_scc0 L_po1
    s_mov_b64 exec, s[36:37]
L_po0:
    buffer_load_dwordx4 v[48:51], v9, s[44:47], s65 offen sc1
    buffer_load_dwordx4 v[52:55], v9, s[44:47], s66 offen sc1
    s_mov_b64 exec, -1
L_po1:
    v_cndmask_b32 v28, v56, v58, s[42:43]
    v_cndmask_b32 v30, v60, v62, s[42:43]
    v_cndmask_b32 v29, v57, v59, s[42:43]
    v_cndmask_b32 v31, v61, v63, s[42:43]
    v_and_b32 v28, 0xfffffc00, v28
    v_and_b32 v30, 0xfffffc00, v30
    v_max_f32 v32, v28, v30
    v_and_b32 v29, 0xfffffc00, v29
    v_and_b32 v31, 0xfffffc00, v31
    v_max_f32_dpp v32, v32, v32 row_ror:4 row_mask:0xf bank_mask:0xf
    s_nop 1
    v_max_f32_dpp v32, v32, v32 row_ror:8 row_mask:0xf bank_mask:0xf
    s_nop 1
    v_max_f32_dpp v32, v32, v32 row_bcast:15 row_mask:0xa bank_mask:0xf
    s_nop 1
    v_max_f32_dpp v32, v32, v32 row_bcast:31 row_mask:0xc bank_mask:0xf
    s_nop 1
    v_readlane_b32 s69, v32, 63
    s_mov_b32 s62, 0x000f000f
    s_mov_b32 s56, 0
    v_subrev_f32 v28, s69, v28
    v_subrev_f32 v30, s69, v30
    v_mul_f32 v28, s59, v28
    v_mul_f32 v30, s59, v30
    v_exp_f32 v28, v28
    v_exp_f32 v30, v30
    s_mov_b32 s63, s62
    v_mul_f32 v29, v28, v29
    v_fmac_f32 v29, v30, v31
    s_nop 1
    v_add_f32_dpp v29, v29, v29 row_ror:4 row_mask:0xf bank_mask:0xf
    s_nop 1
    v_add_f32_dpp v29, v29, v29 row_ror:8 row_mask:0xf bank_mask:0xf
    s_nop 1
    v_add_f32_dpp v29, v29, v29 row_bcast:15 row_mask:0xa bank_mask:0xf
    s_nop 1
    v_add_f32_dpp v29, v29, v29 row_bcast:31 row_mask:0xc bank_mask:0xf
    s_nop 1
    v_readlane_b32 s69, v29, 63
    s_nop 1
    v_rcp_f32 v29, s69
    s_nop 0
    v_mul_f32 v28, v28, v29
    v_mul_f32 v30, v30, v29
    s_and_b64 exec, s[36:37], s[36:37]
    s_cbranch_scc0 L_p1ok
L_p1c:
    buffer_load_dwordx4 v[72:75], v9, s[44:47], s65 offen sc1
    buffer_load_dwordx4 v[76:79], v9, s[44:47], s66 offen sc1
L_p1:
    s_add_u32 s56, s56, 1
    s_waitcnt vmcnt(3)
    v_xor_b32 v64, s58, v48
    v_xor_b32 v65, s58, v49
    v_xor_b32 v66, s58, v50
    v_xor_b32 v67, s58, v51
    v_or3_b32 v17, v64, v65, v66
    s_waitcnt vmcnt(2)
    v_xor_b32 v68, s58, v52
    v_xor_b32 v69, s58, v53
    v_xor_b32 v70, s58, v54
    v_xor_b32 v71, s58, v55
    v_or3_b32 v17, v17, v67, v68
    v_or3_b32 v17, v17, v69, v70
    v_bitop3_b32 v17, v17, v71, v39 bitop3:0xa8
    v_cmp_ne_u32 vcc, 0, v17
    s_and_b64 exec, exec, vcc
    s_cbranch_execz L_p1ok
    buffer_load_dwordx4 v[48:51], v9, s[44:47], s65 offen sc1
    buffer_load_dwordx4 v[52:55], v9, s[44:47], s66 offen sc1
    s_waitcnt vmcnt(3)
    v_xor_b32 v64, s58, v72
    v_xor_b32 v65, s58, v73
    v_xor_b32 v66, s58, v74
    v_xor_b32 v67, s58, v75
    v_or3_b32 v17, v64, v65, v66
    s_waitcnt vmcnt(2)
    v_xor_b32 v68, s58, v76
    v_xor_b32 v69, s58, v77
    v_xor_b32 v70, s58, v78
    v_xor_b32 v71, s58, v79
    v_or3_b32 v17, v17, v67, v68
    v_or3_b32 v17, v17, v69, v70
    v_bitop3_b32 v17, v17, v71, v39 bitop3:0xa8
    v_cmp_ne_u32 vcc, 0, v17
    s_and_b64 exec, exec, vcc
    s_cbranch_execz L_p1ok
    buffer_load_dwordx4 v[72:75], v9, s[44:47], s65 offen sc1
    buffer_load_dwordx4 v[76:79], v9, s[44:47], s66 offen sc1
    s_cmp_lt_u32 s56, 4000000
    s_cbranch_scc1 L_p1
L_p1ok:
    s_mov_b64 exec, -1
    v_mul_f32 v32, v28, v64
    v_mul_f32 v33, v28, v65
    v_mul_f32 v34, v28, v66
    v_mul_f32 v35, v28, v67
    v_fmac_f32 v32, v30, v68
    v_fmac_f32 v33, v30, v69
    v_fmac_f32 v34, v30, v70
    v_fmac_f32 v35, v30, v71
    v_add_f32_dpp v32, v32, v32 row_ror:4 row_mask:0xf bank_mask:0xf
    v_add_f32_dpp v33, v33, v33 row_ror:4 row_mask:0xf bank_mask:0xf
    v_add_f32_dpp v34, v34, v34 row_ror:4 row_mask:0xf bank_mask:0xf
    v_add_f32_dpp v35, v35, v35 row_ror:4 row_mask:0xf bank_mask:0xf
    v_add_f32_dpp v32, v32, v32 row_ror:8 row_mask:0xf bank_mask:0xf
    v_add_f32_dpp v33, v33, v33 row_ror:8 row_mask:0xf bank_mask:0xf
    v_add_f32_dpp v34, v34, v34 row_ror:8 row_mask:0xf bank_mask:0xf
    v_add_f32_dpp v35, v35, v35 row_ror:8 row_mask:0xf bank_mask:0xf
    s_nop 0
    v_permlane16_swap_b32 v32, v33
    v_permlane16_swap_b32 v34, v35
    v_add_f32 v32, v32, v33
    v_add_f32 v34, v34, v35
    s_nop 1
    v_permlane32_swap_b32 v32, v34
    v_add_f32 v32, v32, v34
    v_cvt_pk_bf16_f32 v32, v32, v32
    s_mov_b64 exec, s[62:63]
    ds_write_b32 v8, v32 offset:48160
    s_waitcnt lgkmcnt(0)
    s_barrier
L_end:
    s_endpgm

.section .rodata,"a"
.p2align 6
.amdhsa_kernel gated_mix__sliding_block_cached__swiglu_ffn__decode_kernel
  .amdhsa_next_free_vgpr 144
  .amdhsa_next_free_sgpr 102
  .amdhsa_accum_offset 144
  .amdhsa_group_segment_fixed_size 0
  .amdhsa_kernarg_size 104
  .amdhsa_user_sgpr_count 2
  .amdhsa_user_sgpr_kernarg_segment_ptr 1
  .amdhsa_system_sgpr_workgroup_id_x 1
.end_amdhsa_kernel
```
